```python
import torch

def _softmax(x, axis=-1):
    return torch.softmax(x, dim=axis)
def _gelu(x):
    return torch.nn.functional.gelu(x, approximate="tanh")
def _silu(x):
    return torch.nn.functional.silu(x)
def _sigmoid(x):
    return torch.sigmoid(x)
def _layernorm(x, axis=-1, eps=1e-5):
    m = x.mean(dim=axis, keepdim=True)
    v = x.var(dim=axis, keepdim=True, unbiased=False)
    return (x - m) / torch.sqrt(v + eps)
def _scatter_add(tgt, idx, src, axis=0):
    return tgt.clone().index_add_(axis, idx, src)
def _segment_sum(src, seg, n):
    out = torch.zeros((n,) + src.shape[1:], dtype=src.dtype)
    return out.index_add_(0, seg, src)
def _pad(x, pw):
    flat = tuple(v for pair in reversed(pw) for v in pair)
    return torch.nn.functional.pad(x, flat)

kernel_name = 'standalone__paged_block_table_kv_pagedattention__sampling'

def setup_inputs():

    _w = (lambda a: (lambda t: t.to(torch.bfloat16) if t.is_floating_point() else t)(torch.as_tensor(a)))
    B, Hq, Hkv, Sq, Skv, D = 32, 32, 16, 16, 2048, 128
    bs = 16
    nbps = max(1, Skv // bs)
    num_phys = B * nbps + 4
    bt = torch.randperm(num_phys)[: B * nbps].reshape(B, nbps).to(torch.int64)
    cl = (nbps * bs - (torch.arange(1, B + 1, dtype=torch.int64) * 2654435761) % max(1, nbps * bs // 2)).to(torch.int64)
    return {
        "q": _w((lambda *s: torch.randn(*s, dtype=torch.bfloat16) * 0.8)(B, Hq, Sq, D)),
        "k_cache": _w((lambda *s: torch.randn(*s, dtype=torch.bfloat16) * 0.8)(num_phys, bs, Hkv, D)),
        "v_cache": _w((lambda *s: torch.randn(*s, dtype=torch.bfloat16) * 0.05)(num_phys, bs, Hkv, D)),
        "block_table": _w(bt),
        "context_lens": _w(cl),
    }

def reference(q, k_cache, v_cache, block_table, context_lens):
    B, Hq, Sq, D = q.shape
    bs = k_cache.shape[1]
    Hkv = k_cache.shape[2]
    nbps = block_table.shape[1]
    Skv = nbps * bs
    bt = block_table.reshape(-1)
    k = (lambda x, *d: x.permute(*d))(k_cache[bt].reshape(B, Skv, Hkv, D), 0, 2, 1, 3)
    v = (lambda x, *d: x.permute(*d))(v_cache[bt].reshape(B, Skv, Hkv, D), 0, 2, 1, 3)
    g = Hq // Hkv
    qg = q.reshape(B, Hkv, g, Sq, D)
    scores = torch.einsum("bhgqd,bhkd->bhgqk", qg, k) * (D ** -0.5)
    pos = torch.arange(Skv)
    msk = pos[None, :] < context_lens[:, None]
    scores = torch.where(msk[:, None, None, None, :], scores, -1e9)
    p = _softmax(scores, axis=-1)
    out = torch.einsum("bhgqk,bhkd->bhgqd", p, v)
    return out.reshape(B, Hq, Sq, D)
```

```asm
; @launch grid=(256,1,1) block=(448,1,1) lds=154304
.amdgcn_target "amdgcn-amd-amdhsa--gfx950"
.text
.globl standalone__paged_block_table_kv_pagedattention__sampling_kernel
.p2align 8
.type standalone__paged_block_table_kv_pagedattention__sampling_kernel,@function
standalone__paged_block_table_kv_pagedattention__sampling_kernel:
    s_cmp_ge_u32 s2, 256
    s_cbranch_scc1 L_done
    s_load_dwordx8 s[4:11], s[0:1], 0
    s_load_dwordx4 s[12:15], s[0:1], 32
    s_load_dwordx2 s[82:83], s[0:1], 48
    v_and_b32 v1, 63, v0
    v_lshrrev_b32 v2, 6, v0
    s_mov_b32 s36, 0x60b0513
    s_mov_b32 s37, 0x19121602
    s_mov_b32 s38, 0x8091800
    s_mov_b32 s39, 0xd1e0117
    s_mov_b32 s40, 0xf1c1f0c
    s_mov_b32 s41, 0xa070315
    s_mov_b32 s42, 0x1d0e111a
    s_mov_b32 s43, 0x1b101404
    v_readfirstlane_b32 s3, v2
    s_and_b32 m0, s2, 7
    s_bfe_u32 s46, s2, 0x40003
    s_movrels_b32 s51, s36
    s_lshr_b32 s50, s2, 3
    s_and_b32 s50, s50, 16
    s_lshr_b32 s51, s51, s50
    s_and_b32 s44, s51, 31
    s_bfe_u32 s45, s51, 0x50008
    v_lshrrev_b32 v5, 4, v1
    v_and_b32 v3, 15, v1
    v_lshlrev_b32 v4, 2, v5
    v_xor_b32 v3, v3, v4
    v_lshlrev_b32 v3, 4, v3
    s_mov_b32 s27, 0x20000
    s_cmp_lg_u32 s3, 0
    s_cbranch_scc1 L_cons
    s_setprio 3
    v_lshlrev_b32 v2, 2, v1
    s_lshl_b32 s50, s44, 9
    s_movk_i32 s26, 16384
    s_lshl_b32 s65, s46, 8
    v_lshl_add_u32 v6, v5, 12, v3
    v_add_u32 v6, s65, v6
    v_xor_b32 v7, 16, v6
    v_add_u32 v7, 15360, v7
    v_xor_b32 v8, 32, v6
    v_add_u32 v8, 30720, v8
    v_xor_b32 v9, 48, v6
    v_add_u32 v9, 46080, v9
    s_mov_b32 s19, s27
    s_mov_b32 s18, 268697600
    s_waitcnt lgkmcnt(0)
    s_load_dwordx4 s[76:79], s[10:11], s50
    s_mov_b64 s[24:25], s[10:11]
    buffer_load_dword v10, v2, s[24:27], s50 offen
    s_mov_b64 s[16:17], s[6:7]
    s_mov_b32 m0, 0
    s_mov_b32 s66, 0x14ccc
    v_mov_b32 v16, 154240
    v_mov_b32 v17, s66
    s_mov_b32 s62, 4
    s_mov_b32 s63, 16
    s_mov_b32 s67, 0xffff
    s_movk_i32 s68, 4096
    s_mov_b32 s69, s18
    v_add_u32 v2, 152960, v2
    s_waitcnt lgkmcnt(0)
L_ld_burst:
    s_lshl_b32 s65, s76, 16
    s_mov_b32 s76, s77
    buffer_load_dwordx4 v6, s[16:19], s65 offen offset:0 nt lds
    buffer_load_dwordx4 v7, s[16:19], s65 offen offset:1024 nt lds
    buffer_load_dwordx4 v8, s[16:19], s65 offen offset:2048 nt lds
    buffer_load_dwordx4 v9, s[16:19], s65 offen offset:3072 nt lds
    s_mov_b32 s77, s78
    s_mov_b32 s78, s79
    s_add_u32 m0, m0, s68
    s_cmp_lg_u32 m0, 16384
    s_cbranch_scc1 L_ld_burst
    ds_write_b32 v16, v17
    s_waitcnt vmcnt(16) lgkmcnt(0)
    v_lshlrev_b32 v10, 16, v10
    v_or_b32 v10, 0x8000, v10
    s_call_b64 s[72:73], L_pages
    s_branch L_ld_init
    s_endpgm
    s_endpgm
    s_endpgm
    s_endpgm
    s_endpgm
L_pages:
    v_readlane_b32 s50, v10, s62
    s_and_b32 s51, s50, s67
    s_sub_u32 s65, s50, s51
    s_add_u32 s50, s50, s51
    s_min_u32 s18, s50, s69
    s_bitcmp1_b32 s66, 17
    s_cbranch_scc1 L_lv2_1
    s_bitcmp1_b32 s66, 16
    s_cbranch_scc1 L_lv1_0
    s_waitcnt vmcnt(19)
    buffer_load_dwordx4 v6, s[16:19], s65 offen offset:0 nt lds
    s_waitcnt vmcnt(19)
    buffer_load_dwordx4 v7, s[16:19], s65 offen offset:1024 nt lds
    s_waitcnt vmcnt(19)
    buffer_load_dwordx4 v8, s[16:19], s65 offen offset:2048 nt lds
    s_waitcnt vmcnt(19)
    s_branch L_pg_tail
L_lv1_0:
    s_waitcnt vmcnt(21)
    buffer_load_dwordx4 v6, s[16:19], s65 offen offset:0 nt lds
    s_waitcnt vmcnt(21)
    buffer_load_dwordx4 v7, s[16:19], s65 offen offset:1024 nt lds
    s_waitcnt vmcnt(21)
    buffer_load_dwordx4 v8, s[16:19], s65 offen offset:2048 nt lds
    s_waitcnt vmcnt(21)
    s_branch L_pg_tail
L_lv2_1:
    s_bitcmp1_b32 s66, 16
    s_cbranch_scc1 L_lv3_0
    s_waitcnt vmcnt(23)
    buffer_load_dwordx4 v6, s[16:19], s65 offen offset:0 nt lds
    s_waitcnt vmcnt(23)
    buffer_load_dwordx4 v7, s[16:19], s65 offen offset:1024 nt lds
    s_waitcnt vmcnt(23)
    buffer_load_dwordx4 v8, s[16:19], s65 offen offset:2048 nt lds
    s_waitcnt vmcnt(23)
    s_branch L_pg_tail
L_lv3_0:
    s_waitcnt vmcnt(25)
    buffer_load_dwordx4 v6, s[16:19], s65 offen offset:0 nt lds
    s_waitcnt vmcnt(25)
    buffer_load_dwordx4 v7, s[16:19], s65 offen offset:1024 nt lds
    s_waitcnt vmcnt(25)
    buffer_load_dwordx4 v8, s[16:19], s65 offen offset:2048 nt lds
    s_waitcnt vmcnt(25)
L_pg_tail:
    buffer_load_dwordx4 v9, s[16:19], s65 offen offset:3072 nt lds
    s_waitcnt lgkmcnt(0)
    v_readfirstlane_b32 s66, v17
    ds_read_b32 v17, v16
    s_add_u32 s62, s62, 1
    s_add_u32 m0, m0, s68
    s_cmp_lt_u32 s62, s63
    s_cbranch_scc1 L_pages
    s_setpc_b64 s[72:73]
L_store0:
    s_and_b32 s3, s3, 1
    s_cselect_b32 s51, s45, s44
    s_lshl_b32 s51, s51, 9
    s_movk_i32 s26, 16384
    v_lshlrev_b32 v12, 2, v1
    s_waitcnt lgkmcnt(0)
    s_mov_b64 s[24:25], s[10:11]
    buffer_load_dword v8, v12, s[24:27], s51 offen
    buffer_load_dword v9, v12, s[24:27], s51 offen offset:256
    s_load_dword s48, s[12:13], s52
    s_load_dword s49, s[12:13], s53
    s_branch L_store
L_cons:
    s_lshl_b32 s52, s44, 2
    s_lshl_b32 s53, s45, 2
    s_sub_u32 s3, s3, 1
    s_cmp_gt_u32 s3, 3
    s_cbranch_scc1 L_store0
    v_lshl_add_u32 v4, v5, 8, v3
    s_lshl_b32 s50, s3, 5
    s_and_b32 s50, s50, 32
    v_xor_b32 v4, s50, v4
    v_xor_b32 v2, 16, v4
    s_mov_b32 s26, 4194304
    s_lshl_b32 s50, s3, 11
    s_lshl4_add_u32 s64, s44, s46
    s_lshl4_add_u32 s65, s45, s46
    s_lshl_b32 s64, s64, 13
    s_lshl_b32 s65, s65, 13
    s_add_u32 s51, s64, s50
    s_add_u32 m0, s50, 98304
    s_waitcnt lgkmcnt(0)
    s_mov_b64 s[24:25], s[4:5]
    buffer_load_dwordx4 v4, s[24:27], s51 offen nt lds
    buffer_load_dwordx4 v2, s[24:27], s51 offen offset:1024 nt lds
    s_add_u32 m0, s50, 106496
    s_add_u32 s51, s65, s50
    buffer_load_dwordx4 v4, s[24:27], s51 offen nt lds
    buffer_load_dwordx4 v2, s[24:27], s51 offen offset:1024 nt lds
    s_load_dword s48, s[12:13], s52
    s_load_dword s49, s[12:13], s53
    v_and_b32 v2, 3, v1
    v_lshlrev_b32 v2, 2, v2
    v_bfe_u32 v3, v1, 2, 2
    v_or_b32 v2, v2, v3
    v_lshrrev_b32 v3, 5, v1
    v_lshlrev_b32 v21, 2, v3
    v_xor_b32 v2, v2, v3
    v_lshlrev_b32 v2, 4, v2
    v_and_b32 v4, 31, v1
    v_lshl_add_u32 v6, v4, 8, v2
    v_xor_b32 v7, 32, v6
    v_xor_b32 v8, 64, v6
    v_xor_b32 v9, 96, v6
    v_xor_b32 v10, 128, v6
    v_xor_b32 v11, 160, v6
    v_xor_b32 v12, 192, v6
    v_xor_b32 v13, 224, v6
    s_branch L_cons2
L_ld_init:
    s_waitcnt vmcnt(28)
    s_barrier
    ds_read_b32 v15, v2 offset:1024
    ds_read_b32 v11, v2 offset:0
    ds_read_b32 v12, v2 offset:256
    ds_read_b32 v13, v2 offset:512
    ds_read_b32 v14, v2 offset:768
    s_mov_b32 s29, 1
    s_mov_b32 s35, 32768
    s_mov_b32 s64, -1
    s_waitcnt lgkmcnt(0)
    v_readlane_b32 s32, v15, 63
    s_mov_b32 s28, 0
    s_mov_b32 s30, 0
    s_lshr_b32 s31, s32, 1
    s_cmp_le_u32 s32, 27
    s_cselect_b32 s31, s32, s31
    s_branch L_ld_adv
L_ld_pass:
    v_readlane_b32 s33, v15, s29
    s_lshr_b32 s50, s29, 3
    s_set_gpr_idx_on s50, gpr_idx(SRC0)
    v_mov_b32 v10, v11
    s_set_gpr_idx_off
    s_mov_b32 m0, s35
    s_and_b32 s62, s29, 7
    s_lshl_b32 s62, s62, 3
    s_and_b32 s34, s33, 15
    s_add_u32 s63, s62, s34
    s_cmp_eq_u32 s29, s64
    s_cbranch_scc1 L_ld_last
    s_call_b64 s[72:73], L_pages
    s_cmp_ge_u32 s34, 7
    s_cbranch_scc1 L_ld_g
    s_waitcnt vmcnt(0)
L_ld_g:
    s_waitcnt vmcnt(28)
    s_barrier
L_ld_adv:
    s_add_u32 s35, s35, 32768
    s_cmp_eq_u32 s35, 98304
    s_cselect_b32 s35, 0, s35
    s_add_u32 s29, s29, 1
    s_cmp_lt_u32 s29, s31
    s_cbranch_scc1 L_ld_pass
    s_xor_b32 s28, s28, 1
    s_cbranch_scc0 L_ld_tok
    s_mov_b32 s29, s30
    s_mov_b64 s[16:17], s[8:9]
    s_sub_u32 s64, s32, 1
    s_branch L_ld_pass
L_ld_tok:
    s_mov_b32 s30, s31
    s_mov_b32 s31, s32
    s_mov_b64 s[16:17], s[6:7]
    s_mov_b32 s64, -1
    s_branch L_ld_pass
L_ld_last:
    s_cmp_eq_u32 s34, 8
    s_cbranch_scc0 L_ld_short
    s_sub_u32 s63, s63, 2
    s_call_b64 s[72:73], L_pages
    s_waitcnt vmcnt(24)
    s_barrier
    s_add_u32 s63, s63, 2
    s_call_b64 s[72:73], L_pages
    s_waitcnt vmcnt(8)
L_ld_end:
    s_barrier
    s_waitcnt vmcnt(0)
    s_barrier
    s_endpgm
L_ld_short:
    s_call_b64 s[72:73], L_pages
    s_waitcnt vmcnt(0)
    s_branch L_ld_end
L_cons2:
    s_lshl_b32 s50, s3, 2
    s_add_u32 s50, s50, 147456
    v_lshl_add_u32 v18, v4, 4, s50
    s_mov_b32 s50, 147456
    v_lshl_add_u32 v19, v4, 4, s50
    v_add_u32 v145, 1024, v18
    v_add_u32 v146, 1024, v19
    s_mov_b32 s50, 149504
    v_lshl_add_u32 v144, v4, 2, s50
    s_mov_b32 s50, 114688
    v_lshl_add_u32 v16, v1, 4, s50
    s_lshl_b32 s50, s3, 11
    v_add_u32 v17, s50, v16
    s_lshl_b32 s50, s3, 6
    v_and_b32 v2, 15, v1
    v_lshl_add_u32 v20, v2, 8, s50
    v_and_b32 v2, 16, v1
    v_lshl_add_u32 v20, v2, 1, v20
    v_lshl_add_u32 v20, v3, 4, v20
    v_bfe_u32 v2, v1, 2, 2
    v_lshl_add_u32 v4, v3, 2, v2
    v_lshlrev_b32 v4, 8, v4
    v_lshl_add_u32 v4, v2, 6, v4
    v_bfe_u32 v2, v1, 4, 1
    v_lshlrev_b32 v2, 1, v2
    v_bfe_u32 v5, v1, 1, 1
    v_or_b32 v2, v2, v5
    v_xor_b32 v2, v2, v3
    v_lshl_add_u32 v4, v2, 4, v4
    v_and_b32 v2, 1, v1
    v_lshl_add_u32 v4, v2, 3, v4
    v_xor_b32 v14, s50, v4
    v_xor_b32 v15, 32, v14
    s_mov_b64 s[40:41], s[14:15]
    s_mov_b32 s42, 4194304
    s_mov_b32 s43, 0x20000
    s_mov_b32 s62, 0x3e0293ee
    s_mov_b32 s63, 0xbe0293ee
    v_mov_b32 v26, 0xff800000
    v_mov_b32 v48, 0
    v_mov_b32 v128, 0
    v_mov_b32 v49, 0
    v_mov_b32 v129, 0
    v_mov_b32 v50, 0
    v_mov_b32 v130, 0
    v_mov_b32 v51, 0
    v_mov_b32 v131, 0
    v_mov_b32 v52, 0
    v_mov_b32 v132, 0
    v_mov_b32 v53, 0
    v_mov_b32 v133, 0
    v_mov_b32 v54, 0
    v_mov_b32 v134, 0
    v_mov_b32 v55, 0
    v_mov_b32 v135, 0
    v_mov_b32 v56, 0
    v_mov_b32 v136, 0
    v_mov_b32 v57, 0
    v_mov_b32 v137, 0
    v_mov_b32 v58, 0
    v_mov_b32 v138, 0
    v_mov_b32 v59, 0
    v_mov_b32 v139, 0
    v_mov_b32 v60, 0
    v_mov_b32 v140, 0
    v_mov_b32 v61, 0
    v_mov_b32 v141, 0
    v_mov_b32 v62, 0
    v_mov_b32 v142, 0
    v_mov_b32 v63, 0
    v_mov_b32 v143, 0
    v_mov_b32 v22, 0xf149f2ca
    v_mul_f32 v25, s63, v22
    v_mov_b32 v23, 0
    v_mov_b32 v149, v22
    v_mov_b32 v151, v25
    v_mov_b32 v150, 0
    s_mov_b32 s68, -1
    s_mov_b32 s69, 0
    s_mov_b32 s70, 0
    s_mov_b32 s71, 0
    s_mov_b32 s29, 0
    s_mov_b32 s35, 0
    s_mov_b32 s51, 153984
    v_lshl_add_u32 v27, v1, 2, s51
    s_waitcnt lgkmcnt(0)
    s_mov_b32 s60, 0
    s_cmp_lt_i32 s48, 1
    s_cselect_b32 s50, 1, 0
    s_or_b32 s60, s60, s50
    s_cmp_lt_i32 s49, 1
    s_cselect_b32 s50, 2, 0
    s_or_b32 s60, s60, s50
    s_waitcnt vmcnt(0)
    s_barrier
    ds_read_b32 v27, v27
    s_waitcnt lgkmcnt(0)
    v_readlane_b32 s32, v27, 63
    s_mov_b32 s28, 0
    s_mov_b32 s30, 0
    s_lshr_b32 s31, s32, 1
    s_cmp_le_u32 s32, 27
    s_cselect_b32 s31, s32, s31
L_c_pass:
    v_readlane_b32 s33, v27, s29
    s_cmp_eq_u32 s28, 1
    s_cbranch_scc1 L_c_v
    s_bfe_u32 s67, s33, 0x1000c
    s_cmp_eq_u32 s67, s68
    s_cbranch_scc1 L_haveq
    s_mov_b32 s68, s67
    s_bitcmp1_b32 s60, s67
    s_cbranch_scc1 L_zeroq
    s_lshl_b32 s50, s67, 13
    s_add_u32 s50, s50, 98304
    v_add_u32 v64, s50, v6
    v_add_u32 v68, s50, v7
    v_add_u32 v72, s50, v8
    v_add_u32 v76, s50, v9
    v_add_u32 v80, s50, v10
    v_add_u32 v84, s50, v11
    v_add_u32 v88, s50, v12
    v_add_u32 v92, s50, v13
    ds_read_b128 v[64:67], v64
    ds_read_b128 v[68:71], v68
    ds_read_b128 v[72:75], v72
    ds_read_b128 v[76:79], v76
    ds_read_b128 v[80:83], v80
    ds_read_b128 v[84:87], v84
    ds_read_b128 v[88:91], v88
    ds_read_b128 v[92:95], v92
L_haveq:
    s_bfe_u32 s66, s33, 0x80004
    s_lshl_b32 s50, s3, 5
    s_sub_i32 s66, s66, s50
    s_lshl_b32 s50, s3, 13
    s_add_u32 s50, s50, s35
    v_add_u32 v96, s50, v6
    v_add_u32 v100, s50, v7
    v_add_u32 v104, s50, v8
    v_add_u32 v108, s50, v9
    v_add_u32 v112, s50, v10
    v_add_u32 v116, s50, v11
    v_add_u32 v120, s50, v12
    v_add_u32 v124, s50, v13
    s_cmp_eq_u32 s29, 0
    s_waitcnt lgkmcnt(0)
    s_cbranch_scc1 L_k_go
    s_barrier
L_k_go:
    ds_read_b128 v[96:99], v96
    ds_read_b128 v[100:103], v100
    ds_read_b128 v[104:107], v104
    ds_read_b128 v[108:111], v108
    ds_read_b128 v[112:115], v112
    ds_read_b128 v[116:119], v116
    ds_read_b128 v[120:123], v120
    ds_read_b128 v[124:127], v124
    s_cmp_eq_u32 s71, 0
    s_cbranch_scc1 L_nosm1
    s_call_b64 s[74:75], L_softmax
L_nosm1:
    s_waitcnt lgkmcnt(0)
    v_mfma_f32_32x32x16_bf16 v[32:47], v[96:99], v[64:67], 0
    v_mfma_f32_32x32x16_bf16 v[32:47], v[100:103], v[68:71], v[32:47]
    v_mfma_f32_32x32x16_bf16 v[32:47], v[104:107], v[72:75], v[32:47]
    v_mfma_f32_32x32x16_bf16 v[32:47], v[108:111], v[76:79], v[32:47]
    v_mfma_f32_32x32x16_bf16 v[32:47], v[112:115], v[80:83], v[32:47]
    v_mfma_f32_32x32x16_bf16 v[32:47], v[116:119], v[84:87], v[32:47]
    v_mfma_f32_32x32x16_bf16 v[32:47], v[120:123], v[88:91], v[32:47]
    v_mfma_f32_32x32x16_bf16 v[32:47], v[124:127], v[92:95], v[32:47]
    v_sub_u32 v5, s66, v21
    v_xor_b32 v19, 512, v19
    v_xor_b32 v18, 512, v18
    s_mov_b32 s71, 1
    s_sub_u32 s72, s29, s30
    s_mov_b32 s73, s67
    s_nop 3
    s_cmp_ge_i32 s66, 32
    s_cbranch_scc1 L_nomask
    v_cmp_lt_i32 s[74:75], 0, v5
    v_cmp_lt_i32 s[76:77], 1, v5
    v_cmp_lt_i32 s[78:79], 2, v5
    v_cmp_lt_i32 s[80:81], 3, v5
    v_cndmask_b32 v32, v26, v32, s[74:75]
    v_cndmask_b32 v33, v26, v33, s[76:77]
    v_cndmask_b32 v34, v26, v34, s[78:79]
    v_cndmask_b32 v35, v26, v35, s[80:81]
    v_cmp_lt_i32 s[74:75], 8, v5
    v_cmp_lt_i32 s[76:77], 9, v5
    v_cmp_lt_i32 s[78:79], 10, v5
    v_cmp_lt_i32 s[80:81], 11, v5
    v_cndmask_b32 v36, v26, v36, s[74:75]
    v_cndmask_b32 v37, v26, v37, s[76:77]
    v_cndmask_b32 v38, v26, v38, s[78:79]
    v_cndmask_b32 v39, v26, v39, s[80:81]
    v_cmp_lt_i32 s[74:75], 16, v5
    v_cmp_lt_i32 s[76:77], 17, v5
    v_cmp_lt_i32 s[78:79], 18, v5
    v_cmp_lt_i32 s[80:81], 19, v5
    v_cndmask_b32 v40, v26, v40, s[74:75]
    v_cndmask_b32 v41, v26, v41, s[76:77]
    v_cndmask_b32 v42, v26, v42, s[78:79]
    v_cndmask_b32 v43, v26, v43, s[80:81]
    v_cmp_lt_i32 s[74:75], 24, v5
    v_cmp_lt_i32 s[76:77], 25, v5
    v_cmp_lt_i32 s[78:79], 26, v5
    v_cmp_lt_i32 s[80:81], 27, v5
    v_cndmask_b32 v44, v26, v44, s[74:75]
    v_cndmask_b32 v45, v26, v45, s[76:77]
    v_cndmask_b32 v46, v26, v46, s[78:79]
    v_cndmask_b32 v47, v26, v47, s[80:81]
L_nomask:
    v_max3_f32 v2, v32, v33, v34
    v_max3_f32 v3, v35, v36, v37
    v_max3_f32 v2, v2, v38, v39
    v_max3_f32 v3, v3, v40, v41
    v_max3_f32 v2, v2, v42, v43
    v_max3_f32 v3, v3, v44, v45
    v_max3_f32 v2, v2, v46, v47
    v_max_f32 v2, v2, v3
    v_mov_b32 v3, v2
    s_nop 1
    v_permlane32_swap_b32 v2, v3
    s_nop 0
    v_max_f32 v2, v2, v3
    ds_write_b32 v18, v2
L_c_adv:
    s_add_u32 s35, s35, 32768
    s_cmp_eq_u32 s35, 98304
    s_cselect_b32 s35, 0, s35
    s_add_u32 s29, s29, 1
    s_cmp_lt_u32 s29, s31
    s_cbranch_scc1 L_c_pass
    s_xor_b32 s28, s28, 1
    s_cbranch_scc0 L_c_tok
    s_mov_b32 s29, s30
    s_branch L_c_pass
L_c_tok:
    s_mov_b32 s30, s31
    s_mov_b32 s31, s32
    s_mov_b32 s68, -1
    s_branch L_c_pass
L_softmax:
    ds_read_b128 v[28:31], v19
    s_cmp_eq_u32 s73, s70
    s_cbranch_scc1 L_sm_own
    s_mov_b32 s70, s73
    v_swap_b32 v22, v149
    v_swap_b32 v25, v151
    v_swap_b32 v23, v150
L_sm_own:
    s_lshl_b32 s50, s72, 7
    v_add_u32 v5, s50, v144
    s_lshl_b32 s51, s72, 3
    s_lshl_b32 s52, s73, 9
    s_waitcnt lgkmcnt(0)
    v_max3_f32 v2, v28, v29, v30
    v_max3_f32 v22, v2, v31, v22
    v_mul_f32 v4, s63, v22
    v_sub_f32 v24, v4, v25
    v_fma_f32 v32, v32, s62, v4
    v_fma_f32 v33, v33, s62, v4
    v_fma_f32 v34, v34, s62, v4
    v_fma_f32 v35, v35, s62, v4
    v_fma_f32 v36, v36, s62, v4
    v_fma_f32 v37, v37, s62, v4
    v_fma_f32 v38, v38, s62, v4
    v_fma_f32 v39, v39, s62, v4
    v_fma_f32 v40, v40, s62, v4
    v_fma_f32 v41, v41, s62, v4
    v_fma_f32 v42, v42, s62, v4
    v_fma_f32 v43, v43, s62, v4
    v_fma_f32 v44, v44, s62, v4
    v_fma_f32 v45, v45, s62, v4
    v_fma_f32 v46, v46, s62, v4
    v_fma_f32 v47, v47, s62, v4
    v_exp_f32 v24, v24
    v_exp_f32 v32, v32
    v_exp_f32 v33, v33
    v_exp_f32 v34, v34
    v_exp_f32 v35, v35
    v_exp_f32 v36, v36
    v_exp_f32 v37, v37
    v_exp_f32 v38, v38
    v_exp_f32 v39, v39
    v_exp_f32 v40, v40
    v_exp_f32 v41, v41
    v_exp_f32 v42, v42
    v_exp_f32 v43, v43
    v_exp_f32 v44, v44
    v_exp_f32 v45, v45
    v_exp_f32 v46, v46
    v_exp_f32 v47, v47
    ds_write_b32 v5, v24
    v_mov_b32 v25, v4
    v_add_f32 v2, v32, v33
    v_add_f32 v3, v34, v35
    v_add_f32 v2, v2, v36
    v_add_f32 v3, v3, v37
    v_add_f32 v2, v2, v38
    v_add_f32 v3, v3, v39
    v_add_f32 v2, v2, v40
    v_add_f32 v3, v3, v41
    v_add_f32 v2, v2, v42
    v_add_f32 v3, v3, v43
    v_add_f32 v2, v2, v44
    v_add_f32 v3, v3, v45
    v_add_f32 v2, v2, v46
    v_add_f32 v3, v3, v47
    v_fma_f32 v23, v23, v24, v2
    v_add_f32 v23, v23, v3
    v_mov_b32 v2, v23
    v_mov_b32 v3, v23
    v_add_u32 v4, s52, v145
    s_cmp_ge_u32 s72, 13
    s_cbranch_scc1 L_spill
    s_set_gpr_idx_on s51, gpr_idx(DST)
    v_cvt_pk_bf16_f32 v152, v32, v33
    v_cvt_pk_bf16_f32 v153, v34, v35
    v_cvt_pk_bf16_f32 v154, v36, v37
    v_cvt_pk_bf16_f32 v155, v38, v39
    v_cvt_pk_bf16_f32 v156, v40, v41
    v_cvt_pk_bf16_f32 v157, v42, v43
    v_cvt_pk_bf16_f32 v158, v44, v45
    v_cvt_pk_bf16_f32 v159, v46, v47
    s_set_gpr_idx_off
L_spilled:
    v_permlane32_swap_b32 v2, v3
    s_mov_b32 s71, 0
    v_add_f32 v2, v2, v3
    ds_write_b32 v4, v2
    s_waitcnt lgkmcnt(0)
    s_setpc_b64 s[74:75]
L_spill:
    s_and_b32 s50, s72, 1
    s_lshl_b32 s50, s50, 13
    s_add_u32 s50, s50, 131072
    v_and_b32 v28, 0x1fff, v17
    v_add_u32 v28, s50, v28
    v_cvt_pk_bf16_f32 v32, v32, v33
    v_cvt_pk_bf16_f32 v33, v34, v35
    v_cvt_pk_bf16_f32 v34, v36, v37
    v_cvt_pk_bf16_f32 v35, v38, v39
    v_cvt_pk_bf16_f32 v36, v40, v41
    v_cvt_pk_bf16_f32 v37, v42, v43
    v_cvt_pk_bf16_f32 v38, v44, v45
    v_cvt_pk_bf16_f32 v39, v46, v47
    ds_write_b128 v28, v[32:35]
    ds_write_b128 v28, v[36:39] offset:1024
    s_branch L_spilled
L_c_v:
    s_sub_u32 s51, s29, s30
    s_lshl_b32 s50, s51, 7
    v_add_u32 v5, s50, v144
    v_xor_b32 v17, 8192, v17
    v_xor_b32 v16, 8192, v16
    ds_read_b32 v24, v5
    s_cmp_ge_u32 s51, 13
    s_cbranch_scc1 L_staged
    s_lshl_b32 s51, s51, 3
    s_set_gpr_idx_on s51, gpr_idx(SRC0)
    v_mov_b32 v96, v152
    v_mov_b32 v97, v153
    v_mov_b32 v98, v154
    v_mov_b32 v99, v155
    v_mov_b32 v100, v156
    v_mov_b32 v101, v157
    v_mov_b32 v102, v158
    v_mov_b32 v103, v159
    s_set_gpr_idx_off
    ds_write_b128 v17, v[96:99]
    ds_write_b128 v17, v[100:103] offset:1024
L_staged:
    v_add_u32 v147, s35, v14
    v_add_u32 v148, s35, v15
    s_and_b32 s34, s33, 15
    s_bfe_u32 s67, s33, 0x1000c
    s_cmp_eq_u32 s67, s69
    s_cbranch_scc1 L_owno
    s_mov_b32 s69, s67
    v_swap_b32 v48, v128
    v_swap_b32 v49, v129
    v_swap_b32 v50, v130
    v_swap_b32 v51, v131
    v_swap_b32 v52, v132
    v_swap_b32 v53, v133
    v_swap_b32 v54, v134
    v_swap_b32 v55, v135
    v_swap_b32 v56, v136
    v_swap_b32 v57, v137
    v_swap_b32 v58, v138
    v_swap_b32 v59, v139
    v_swap_b32 v60, v140
    v_swap_b32 v61, v141
    v_swap_b32 v62, v142
    v_swap_b32 v63, v143
L_owno:
    s_add_u32 s50, s29, 1
    s_cmp_eq_u32 s50, s32
    s_cselect_b32 s66, s34, 0
    s_waitcnt lgkmcnt(0)
    v_pk_mul_f32 v[48:49], v[48:49], v[24:25] op_sel_hi:[1,0]
    v_pk_mul_f32 v[50:51], v[50:51], v[24:25] op_sel_hi:[1,0]
    v_pk_mul_f32 v[52:53], v[52:53], v[24:25] op_sel_hi:[1,0]
    v_pk_mul_f32 v[54:55], v[54:55], v[24:25] op_sel_hi:[1,0]
    v_pk_mul_f32 v[56:57], v[56:57], v[24:25] op_sel_hi:[1,0]
    v_pk_mul_f32 v[58:59], v[58:59], v[24:25] op_sel_hi:[1,0]
    v_pk_mul_f32 v[60:61], v[60:61], v[24:25] op_sel_hi:[1,0]
    v_pk_mul_f32 v[62:63], v[62:63], v[24:25] op_sel_hi:[1,0]
    s_barrier
    s_cmp_eq_u32 s71, 0
    s_cbranch_scc1 L_nosm2
    s_call_b64 s[74:75], L_softmax
L_nosm2:
    s_lshl_b32 s52, s67, 9
    v_add_u32 v5, s52, v146
    ds_read_b64_tr_b16 v[64:65], v147 offset:0
    ds_read_b64_tr_b16 v[66:67], v148 offset:2048
    ds_read_b128 v[96:99], v16 offset:0
    ds_read_b64_tr_b16 v[68:69], v147 offset:4096
    ds_read_b64_tr_b16 v[70:71], v148 offset:6144
    ds_read_b128 v[100:103], v16 offset:1024
    ds_read_b64_tr_b16 v[72:73], v147 offset:8192
    ds_read_b64_tr_b16 v[74:75], v148 offset:10240
    ds_read_b128 v[104:107], v16 offset:2048
    ds_read_b64_tr_b16 v[76:77], v147 offset:12288
    ds_read_b64_tr_b16 v[78:79], v148 offset:14336
    ds_read_b128 v[108:111], v16 offset:3072
    ds_read_b64_tr_b16 v[80:81], v147 offset:16384
    ds_read_b64_tr_b16 v[82:83], v148 offset:18432
    ds_read_b128 v[112:115], v16 offset:4096
    s_waitcnt lgkmcnt(12)
    v_mfma_f32_32x32x16_bf16 v[48:63], v[64:67], v[96:99], v[48:63]
    s_cmp_eq_u32 s34, 1
    s_cbranch_scc1 L_pv_short
    ds_read_b64_tr_b16 v[84:85], v147 offset:20480
    ds_read_b64_tr_b16 v[86:87], v148 offset:22528
    ds_read_b128 v[116:119], v16 offset:5120
    s_waitcnt lgkmcnt(12)
    v_mfma_f32_32x32x16_bf16 v[48:63], v[68:71], v[100:103], v[48:63]
    s_cmp_eq_u32 s34, 2
    s_cbranch_scc1 L_pv_short
    ds_read_b128 v[120:123], v16 offset:6144
    ds_read_b128 v[124:127], v16 offset:7168
    ds_read_b128 v[28:31], v5
    s_waitcnt lgkmcnt(12)
    v_mfma_f32_32x32x16_bf16 v[48:63], v[72:75], v[104:107], v[48:63]
    s_cmp_eq_u32 s34, 3
    s_cbranch_scc1 L_pv_done
    s_waitcnt lgkmcnt(9)
    v_mfma_f32_32x32x16_bf16 v[48:63], v[76:79], v[108:111], v[48:63]
    s_cmp_eq_u32 s34, 4
    s_cbranch_scc1 L_pv_done
    s_waitcnt lgkmcnt(6)
    v_mfma_f32_32x32x16_bf16 v[48:63], v[80:83], v[112:115], v[48:63]
    s_cmp_eq_u32 s34, 5
    s_cbranch_scc1 L_pv_done
    s_waitcnt lgkmcnt(3)
    v_mfma_f32_32x32x16_bf16 v[48:63], v[84:87], v[116:119], v[48:63]
    s_cmp_eq_u32 s34, 6
    s_cbranch_scc1 L_pv_done
    s_cmp_eq_u32 s66, 8
    s_cbranch_scc0 L_nosplit
    s_barrier
L_nosplit:
    ds_read_b64_tr_b16 v[88:89], v147 offset:24576
    ds_read_b64_tr_b16 v[90:91], v148 offset:26624
    ds_read_b64_tr_b16 v[92:93], v147 offset:28672
    ds_read_b64_tr_b16 v[94:95], v148 offset:30720
    s_waitcnt lgkmcnt(2)
    v_mfma_f32_32x32x16_bf16 v[48:63], v[88:91], v[120:123], v[48:63]
    s_cmp_eq_u32 s34, 7
    s_cbranch_scc1 L_pv_done
    s_waitcnt lgkmcnt(0)
    v_mfma_f32_32x32x16_bf16 v[48:63], v[92:95], v[124:127], v[48:63]
L_pv_done:
    s_bitcmp1_b32 s33, 13
    s_waitcnt lgkmcnt(0)
    s_cbranch_scc0 L_c_adv
    v_add_f32 v2, v28, v29
    v_add_f32 v3, v30, v31
    v_add_f32 v2, v2, v3
    v_rcp_f32 v2, v2
    s_cmp_eq_u32 s67, 0
    s_cselect_b32 s51, s64, s65
    s_add_u32 s50, s51, 4096
    s_nop 1
    v_pk_mul_f32 v[32:33], v[48:49], v[2:3] op_sel_hi:[1,0]
    v_pk_mul_f32 v[34:35], v[50:51], v[2:3] op_sel_hi:[1,0]
    v_pk_mul_f32 v[36:37], v[52:53], v[2:3] op_sel_hi:[1,0]
    v_pk_mul_f32 v[38:39], v[54:55], v[2:3] op_sel_hi:[1,0]
    v_pk_mul_f32 v[40:41], v[56:57], v[2:3] op_sel_hi:[1,0]
    v_pk_mul_f32 v[42:43], v[58:59], v[2:3] op_sel_hi:[1,0]
    v_pk_mul_f32 v[44:45], v[60:61], v[2:3] op_sel_hi:[1,0]
    v_pk_mul_f32 v[46:47], v[62:63], v[2:3] op_sel_hi:[1,0]
    v_cvt_pk_bf16_f32 v32, v32, v33
    v_cvt_pk_bf16_f32 v33, v34, v35
    v_cvt_pk_bf16_f32 v34, v36, v37
    v_cvt_pk_bf16_f32 v35, v38, v39
    v_cvt_pk_bf16_f32 v36, v40, v41
    v_cvt_pk_bf16_f32 v37, v42, v43
    v_cvt_pk_bf16_f32 v38, v44, v45
    v_cvt_pk_bf16_f32 v39, v46, v47
    s_nop 0
    v_permlane32_swap_b32 v32, v34
    v_permlane32_swap_b32 v33, v35
    v_permlane32_swap_b32 v36, v38
    v_permlane32_swap_b32 v37, v39
    s_cmp_eq_u32 s66, 0
    v_permlane16_swap_b32 v32, v36
    v_permlane16_swap_b32 v33, v37
    v_permlane16_swap_b32 v34, v38
    v_permlane16_swap_b32 v35, v39
    buffer_store_dwordx4 v[32:35], v20, s[40:43], s51 offen
    buffer_store_dwordx4 v[36:39], v20, s[40:43], s50 offen
    s_cbranch_scc1 L_c_adv
    s_endpgm
L_pv_short:
    ds_read_b128 v[28:31], v5
    s_branch L_pv_done
L_zeroq:
    v_mov_b32 v64, 0
    v_mov_b32 v65, 0
    v_mov_b32 v66, 0
    v_mov_b32 v67, 0
    v_mov_b32 v68, 0
    v_mov_b32 v69, 0
    v_mov_b32 v70, 0
    v_mov_b32 v71, 0
    v_mov_b32 v72, 0
    v_mov_b32 v73, 0
    v_mov_b32 v74, 0
    v_mov_b32 v75, 0
    v_mov_b32 v76, 0
    v_mov_b32 v77, 0
    v_mov_b32 v78, 0
    v_mov_b32 v79, 0
    v_mov_b32 v80, 0
    v_mov_b32 v81, 0
    v_mov_b32 v82, 0
    v_mov_b32 v83, 0
    v_mov_b32 v84, 0
    v_mov_b32 v85, 0
    v_mov_b32 v86, 0
    v_mov_b32 v87, 0
    v_mov_b32 v88, 0
    v_mov_b32 v89, 0
    v_mov_b32 v90, 0
    v_mov_b32 v91, 0
    v_mov_b32 v92, 0
    v_mov_b32 v93, 0
    v_mov_b32 v94, 0
    v_mov_b32 v95, 0
    s_branch L_haveq
L_store:
    s_lshl_b32 s50, s3, 12
    v_lshl_add_u32 v7, v1, 4, s50
    v_add_u32 v6, 114688, v7
    s_mov_b64 s[54:55], 0
    s_mov_b32 s58, 0
    s_mov_b32 s29, 0
    s_mov_b64 s[20:21], s[82:83]
    s_movk_i32 s22, 128
    s_mov_b32 s23, 0x20000
    s_lshr_b32 s50, s2, 3
    s_lshl_b32 s50, s50, 2
    v_lshl_add_u32 v13, v1, 8, s50
    s_getreg_b32 s50, hwreg(HW_REG_XCC_ID, 0, 3)
    s_lshl_b32 s50, s50, 2
    s_lshr_b32 s50, 0x788b4a5b, s50
    s_and_b32 s50, s50, 15
    s_mul_i32 s50, s50, 1638
    s_add_u32 s59, s50, 261020
    s_waitcnt lgkmcnt(0)
    s_cmp_lt_i32 s48, 1
    s_cselect_b32 s48, 2048, s48
    s_min_i32 s48, s48, 2048
    s_cmp_lt_i32 s49, 1
    s_cselect_b32 s49, 2048, s49
    s_min_i32 s49, s49, 2048
    s_add_u32 s50, s48, 15
    s_lshr_b32 s50, s50, 4
    s_add_u32 s51, s49, 15
    s_lshr_b32 s51, s51, 4
    s_add_u32 s56, s50, s51
    s_sub_u32 s56, 512, s56
    s_lshl_b32 s56, s56, 1
    s_add_u32 s52, s50, 7
    s_lshr_b32 s52, s52, 3
    s_max_u32 s52, s52, 2
    s_add_u32 s53, s51, 7
    s_lshr_b32 s53, s53, 3
    s_add_u32 s32, s52, s53
    s_sub_u32 s52, s52, 2
    s_cmp_eq_u32 s3, 0
    s_cselect_b32 s60, s48, s49
    s_cselect_b32 s61, s50, s51
    s_cselect_b32 s62, s52, s53
    s_cselect_b32 s63, s53, s52
    s_cselect_b32 s64, 2, 0
    s_sub_u32 s65, 0, s61
    s_and_b32 s65, s65, 7
    s_cmp_gt_u32 s62, s65
    s_cselect_b32 s65, s65, 0
    v_subrev_u32 v2, s64, v1
    v_lshl_add_u32 v3, v2, 1, 1
    v_mul_lo_u32 v3, v3, s63
    v_add_u32 v3, s3, v3
    s_lshl_b32 s50, s3, 1
    v_add_u32 v14, s50, v1
    s_mov_b32 s66, s63
    s_mov_b32 s51, s62
L_s_merge:
    s_sub_u32 s66, s66, 1
    s_cbranch_scc1 L_s_merged
    v_cmp_lt_i32 vcc, s51, v3
    s_lshl1_add_u32 s51, s62, s51
    s_nop 0
    v_addc_co_u32 v14, vcc, 0, v14, vcc
    s_branch L_s_merge
L_s_merged:
    v_med3_i32 v3, v2, 0, s65
    v_lshlrev_b32 v15, 3, v1
    v_sub_u32 v15, v15, v3
    v_cmp_gt_u32 vcc, s65, v2
    v_lshlrev_b32 v4, 4, v15
    v_sub_u32 v4, s60, v4
    v_cndmask_b32 v3, 8, 7, vcc
    v_lshlrev_b32 v3, 4, v3
    v_med3_i32 v4, v4, 0, v3
    v_add_u32 v3, 15, v4
    v_lshrrev_b32 v3, 4, v3
    v_max_u32 v3, 1, v3
    v_lshl_add_u32 v3, v4, 4, v3
    s_add_u32 s62, s62, s64
    s_sub_u32 s50, s62, 1
    v_cmp_eq_u32 vcc, s50, v1
    s_lshl_b32 s50, s3, 12
    v_or_b32 v3, s50, v3
    v_or_b32 v4, 0x2000, v3
    v_cndmask_b32 v3, v3, v4, vcc
    v_cmp_gt_u32 vcc, s62, v1
    v_mov_b32 v4, s32
    s_mov_b32 s50, 153984
    v_cndmask_b32 v3, v4, v3, vcc
    v_cndmask_b32 v4, 63, v14, vcc
    v_lshl_add_u32 v4, v4, 2, s50
    ds_write_b32 v4, v3
    v_lshlrev_b32 v14, 3, v14
    v_sub_u32 v14, v14, v15
    s_lshl_b32 s66, s64, 3
    s_sub_i32 s51, s61, s66
    s_sub_i32 s51, s51, 1
    s_max_i32 s51, s51, 0
    v_mov_b32 v18, v1
    v_add_u32 v19, 64, v1
    v_mov_b32 v2, s56
    s_cmp_eq_u32 s3, 0
    s_waitcnt vmcnt(0)
    s_cbranch_scc1 L_s_np0
    buffer_store_dword v2, v13, s[20:23], 0 offen
L_s_np0:
    v_subrev_u32 v3, s66, v18
    v_cmp_gt_u32 vcc, s51, v3
    v_lshrrev_b32 v16, 8, v8
    v_min_u32 v16, 15, v16
    v_cndmask_b32 v16, -1, v16, vcc
    v_subrev_u32 v3, s66, v19
    v_cmp_gt_u32 vcc, s51, v3
    v_lshrrev_b32 v17, 8, v9
    v_min_u32 v17, 15, v17
    v_cndmask_b32 v17, -1, v17, vcc
    s_mov_b32 s51, 0
    s_mov_b32 s52, s66
L_s_sort:
    v_cmp_eq_u32 s[68:69], s51, v16
    v_cmp_eq_u32 s[70:71], s51, v17
    s_add_u32 s51, s51, 1
    v_mbcnt_lo_u32_b32 v3, s68, 0
    v_mbcnt_hi_u32_b32 v3, s69, v3
    v_mbcnt_lo_u32_b32 v4, s70, 0
    v_mbcnt_hi_u32_b32 v4, s71, v4
    v_add_u32 v3, s52, v3
    s_bcnt1_i32_b64 s50, s[68:69]
    s_add_u32 s52, s52, s50
    v_add_u32 v4, s52, v4
    s_bcnt1_i32_b64 s50, s[70:71]
    s_add_u32 s52, s52, s50
    v_cndmask_b32 v18, v18, v3, s[68:69]
    v_cndmask_b32 v19, v19, v4, s[70:71]
    s_cmp_lt_u32 s51, 16
    s_cbranch_scc1 L_s_sort
    s_mul_i32 s51, s65, 7
    s_movk_i32 s52, 9363
    v_subrev_u32 v3, s66, v18
    v_cmp_gt_i32 vcc, 0, v3
    v_mov_b32 v4, s65
    v_cmp_gt_u32 s[68:69], s51, v3
    v_cndmask_b32 v4, v4, 0, vcc
    v_add_u32 v4, v4, v18
    v_lshrrev_b32 v4, 3, v4
    v_mul_u32_u24 v3, s52, v3
    v_lshrrev_b32 v3, 16, v3
    v_add_u32 v3, s64, v3
    v_cndmask_b32 v16, v4, v3, s[68:69]
    v_lshlrev_b32 v3, 2, v16
    ds_bpermute_b32 v20, v3, v14
    v_lshlrev_b32 v4, 4, v18
    v_sub_u32 v4, s60, v4
    v_med3_i32 v4, v4, 0, 16
    v_lshlrev_b32 v4, 11, v4
    v_lshl_add_u32 v8, v8, 16, v4
    v_subrev_u32 v3, s66, v19
    v_cmp_gt_i32 vcc, 0, v3
    v_mov_b32 v4, s65
    v_cmp_gt_u32 s[68:69], s51, v3
    v_cndmask_b32 v4, v4, 0, vcc
    v_add_u32 v4, v4, v19
    v_lshrrev_b32 v4, 3, v4
    v_mul_u32_u24 v3, s52, v3
    v_lshrrev_b32 v3, 16, v3
    v_add_u32 v3, s64, v3
    v_cndmask_b32 v17, v4, v3, s[68:69]
    v_lshlrev_b32 v3, 2, v17
    ds_bpermute_b32 v21, v3, v14
    v_lshlrev_b32 v4, 4, v19
    v_sub_u32 v4, s60, v4
    v_med3_i32 v4, v4, 0, 16
    v_lshlrev_b32 v4, 11, v4
    v_lshl_add_u32 v9, v9, 16, v4
    s_mov_b32 s50, 152960
    v_mov_b32 v4, 328
    s_waitcnt lgkmcnt(0)
    v_cmp_gt_u32 vcc, s62, v16
    v_add_u32 v3, v20, v18
    s_nop 0
    v_cndmask_b32 v3, v4, v3, vcc
    v_lshl_add_u32 v3, v3, 2, s50
    ds_write_b32 v3, v8
    v_cmp_gt_u32 vcc, s62, v17
    v_add_u32 v3, v21, v19
    s_nop 0
    v_cndmask_b32 v3, v4, v3, vcc
    v_lshl_add_u32 v3, v3, 2, s50
    ds_write_b32 v3, v9
    v_add_u32 v10, 153984, v12
    s_waitcnt lgkmcnt(0)
    s_barrier
    ds_read_b32 v10, v10
    s_waitcnt lgkmcnt(0)
    v_readlane_b32 s32, v10, 63
    s_mov_b32 s28, 0
    s_mov_b32 s30, 0
    s_lshr_b32 s31, s32, 1
    s_cmp_le_u32 s32, 27
    s_cselect_b32 s31, s32, s31
    v_readlane_b32 s33, v10, 0
    s_branch L_s_go
L_s_pass:
    v_readlane_b32 s33, v10, s29
    s_cmp_eq_u32 s28, 1
    s_cbranch_scc0 L_s_tick
    v_xor_b32 v6, 8192, v6
    s_sub_u32 s51, s29, s30
    s_sub_u32 s51, s51, 13
    s_cbranch_scc1 L_s_chkend
    s_lshl_b32 s51, s51, 4
    s_set_gpr_idx_on s51, gpr_idx(SRC0)
    v_mov_b32 v16, v32
    v_mov_b32 v17, v33
    v_mov_b32 v18, v34
    v_mov_b32 v19, v35
    v_mov_b32 v20, v36
    v_mov_b32 v21, v37
    v_mov_b32 v22, v38
    v_mov_b32 v23, v39
    v_mov_b32 v24, v40
    v_mov_b32 v25, v41
    v_mov_b32 v26, v42
    v_mov_b32 v27, v43
    v_mov_b32 v28, v44
    v_mov_b32 v29, v45
    v_mov_b32 v30, v46
    v_mov_b32 v31, v47
    s_set_gpr_idx_off
    ds_write_b128 v6, v[16:19] offset:0
    ds_write_b128 v6, v[20:23] offset:1024
    ds_write_b128 v6, v[24:27] offset:2048
    ds_write_b128 v6, v[28:31] offset:3072
L_s_chkend:
    s_add_u32 s50, s29, 1
    s_cmp_eq_u32 s50, s32
    s_waitcnt lgkmcnt(0)
    s_cbranch_scc0 L_s_tick
    s_barrier
    s_endpgm
L_s_tick:
    s_barrier
L_s_go:
    s_and_b32 s34, s33, 15
    s_add_u32 s56, s56, s34
    s_cmp_eq_u32 s3, 0
    s_cbranch_scc1 L_ctl1
    v_mov_b32 v2, s56
    buffer_store_dword v2, v13, s[20:23], 0 offen
    s_branch L_ctl2
L_ctl1:
    s_waitcnt vmcnt(0)
    v_cmp_ne_u32 vcc, 0, v13
    v_sub_u32 v11, s57, v13
    buffer_load_dword v13, v12, s[20:23], 0 offen sc1
    s_mov_b32 s57, s56
    s_cmp_eq_u32 s58, 0
    s_mov_b32 s58, 1
    s_cbranch_scc1 L_ctl2
    v_cndmask_b32 v11, 0, v11, vcc
    s_nop 1
    v_add_u32_dpp v11, v11, v11 row_shr:1 row_mask:0xf bank_mask:0xf bound_ctrl:0
    s_nop 1
    v_add_u32_dpp v11, v11, v11 row_shr:2 row_mask:0xf bank_mask:0xf bound_ctrl:0
    s_nop 1
    v_add_u32_dpp v11, v11, v11 row_shr:4 row_mask:0xf bank_mask:0xf bound_ctrl:0
    s_nop 1
    v_add_u32_dpp v11, v11, v11 row_shr:8 row_mask:0xf bank_mask:0xf bound_ctrl:0
    s_nop 0
    v_readlane_b32 s50, v11, 15
    v_readlane_b32 s51, v11, 31
    s_add_i32 s50, s50, s51
    s_min_i32 s50, s50, 1024
    s_max_i32 s50, s50, -1024
    s_mul_i32 s51, s50, 1280
    s_sub_i32 s51, s59, s51
    s_min_i32 s51, s51, 196608
    s_max_i32 s51, s51, 0
    v_mov_b32 v3, 154240
    v_mov_b32 v4, s51
    ds_write_b32 v3, v4
L_ctl2:
    s_sub_u32 s51, s55, 13
    s_cbranch_scc1 L_s_next
    s_and_b32 s50, s55, 1
    s_lshl_b32 s50, s50, 13
    s_add_u32 s50, s50, 131072
    v_add_u32 v2, s50, v7
    ds_read_b128 v[16:19], v2 offset:0
    ds_read_b128 v[20:23], v2 offset:1024
    ds_read_b128 v[24:27], v2 offset:2048
    ds_read_b128 v[28:31], v2 offset:3072
    s_lshl_b32 s51, s51, 4
    s_waitcnt lgkmcnt(0)
    s_set_gpr_idx_on s51, gpr_idx(DST)
    v_mov_b32 v32, v16
    v_mov_b32 v33, v17
    v_mov_b32 v34, v18
    v_mov_b32 v35, v19
    v_mov_b32 v36, v20
    v_mov_b32 v37, v21
    v_mov_b32 v38, v22
    v_mov_b32 v39, v23
    v_mov_b32 v40, v24
    v_mov_b32 v41, v25
    v_mov_b32 v42, v26
    v_mov_b32 v43, v27
    v_mov_b32 v44, v28
    v_mov_b32 v45, v29
    v_mov_b32 v46, v30
    v_mov_b32 v47, v31
    s_set_gpr_idx_off
L_s_next:
    s_mov_b32 s55, s54
    s_sub_u32 s54, s29, s30
    s_cmp_eq_u32 s28, 0
    s_cselect_b32 s54, s54, 0
    s_add_u32 s29, s29, 1
    s_cmp_lt_u32 s29, s31
    s_cbranch_scc1 L_s_pass
    s_xor_b32 s28, s28, 1
    s_cbranch_scc0 L_s_tok
    s_mov_b32 s29, s30
    s_branch L_s_pass
L_s_tok:
    s_mov_b32 s30, s31
    s_mov_b32 s31, s32
    s_branch L_s_pass
L_done:
    s_endpgm
.section .rodata,"a"
.p2align 6
.amdhsa_kernel standalone__paged_block_table_kv_pagedattention__sampling_kernel
  .amdhsa_next_free_vgpr 256
  .amdhsa_next_free_sgpr 96
  .amdhsa_accum_offset 256
  .amdhsa_group_segment_fixed_size 0
  .amdhsa_kernarg_size 64
  .amdhsa_user_sgpr_count 2
  .amdhsa_user_sgpr_kernarg_segment_ptr 1
  .amdhsa_system_sgpr_workgroup_id_x 1
.end_amdhsa_kernel
```
